```python
import torch

def _softmax(x, axis=-1):
    return torch.softmax(x, dim=axis)
def _gelu(x):
    return torch.nn.functional.gelu(x, approximate="tanh")
def _silu(x):
    return torch.nn.functional.silu(x)
def _sigmoid(x):
    return torch.sigmoid(x)
def _layernorm(x, axis=-1, eps=1e-5):
    m = x.mean(dim=axis, keepdim=True)
    v = x.var(dim=axis, keepdim=True, unbiased=False)
    return (x - m) / torch.sqrt(v + eps)
def _scatter_add(tgt, idx, src, axis=0):
    return tgt.clone().index_add_(axis, idx, src)
def _segment_sum(src, seg, n):
    out = torch.zeros((n,) + src.shape[1:], dtype=src.dtype)
    return out.index_add_(0, seg, src)
def _pad(x, pw):
    flat = tuple(v for pair in reversed(pw) for v in pair)
    return torch.nn.functional.pad(x, flat)

kernel_name = 'standalone__instancenorm__prompt'

def setup_inputs():

    _w = (lambda a: (lambda t: t.to(torch.bfloat16) if t.is_floating_point() else t)(torch.as_tensor(a)))
    B, C, H, W = 1, 448, 2048, 16
    return {
        "x": _w(abs((lambda *s: torch.randn(*s, dtype=torch.bfloat16) * 0.05)(B, C, H, W))),
        "g": _w((lambda *s: torch.randn(*s, dtype=torch.bfloat16) * 0.05)(C) + 1.0),
        "b": _w((lambda *s: torch.randn(*s, dtype=torch.bfloat16) * 0.4)(C)),
    }

def reference(x, g, b):
    mu = x.mean(axis=(-2, -1), keepdims=True)
    var = ((x - mu) ** 2).mean(axis=(-2, -1), keepdims=True)
    xhat = (x - mu) / torch.sqrt(var + 1e-5)
    return xhat * g.reshape(1, -1, 1, 1) + b.reshape(1, -1, 1, 1)
```

```asm
; @launch grid=(224,1,1) block=(512,1,1) lds=64
.amdgcn_target "amdgcn-amd-amdhsa--gfx950"
.text
.globl standalone__instancenorm__prompt_kernel
.p2align 12
.p2align 8
.type standalone__instancenorm__prompt_kernel,@function
standalone__instancenorm__prompt_kernel:
    s_load_dwordx4 s[4:7], s[0:1], 0
    s_load_dwordx4 s[8:11], s[0:1], 16
    s_cmp_ge_u32 s2, 224
    s_cbranch_scc1 L_end
    v_readfirstlane_b32 s22, v0
    v_and_b32 v2, 63, v0
    v_lshrrev_b32 v3, 6, v0
    v_lshlrev_b32 v1, 14, v3
    v_lshl_add_u32 v1, v2, 4, v1
    s_lshl_b32 s3, s2, 17
    s_add_u32 s12, s3, 4096
    v_add_u32 v16, s12, v1
    v_add_u32 v17, 0x2000, v16
    s_lshr_b32 s23, s22, 6
    s_lshr_b32 s22, s22, 8
    s_lshl_b32 s28, s2, 1
    s_add_u32 s28, s28, s22
    s_lshl_b32 s3, s28, 16
    s_lshl_b32 s13, s28, 1
    s_and_b32 s13, s13, 0xfffffffc
    s_cmp_lg_u32 s22, 0
    s_cselect_b64 vcc, -1, 0
    v_and_b32 v2, 4, v3
    v_lshlrev_b32 v2, 3, v2
    v_lshlrev_b32 v3, 3, v3
    s_mov_b32 s14, 0x3f803f80
    s_mov_b32 s15, 0xffff0000
    v_mov_b32 v4, 0
    v_mov_b32 v5, 0
    v_mov_b32 v6, 0
    v_mov_b32 v7, 0
    s_mov_b64 exec, 0
    s_cmp_eq_u32 s23, 6
    s_cbranch_scc1 L_pad0
    s_cmp_eq_u32 s23, 7
    s_cbranch_scc1 L_pad1
    s_cmp_eq_u32 s23, 5
    s_cbranch_scc1 L_pad2
L_resume:
    s_mov_b64 exec, -1
    s_waitcnt lgkmcnt(0)
    global_load_dwordx4 v[20:23], v16, s[4:5] offset:-4096 nt
    global_load_dwordx4 v[24:27], v16, s[4:5] offset:-3072 nt
    global_load_dwordx4 v[28:31], v16, s[4:5] offset:-2048 nt
    global_load_dwordx4 v[32:35], v16, s[4:5] offset:-1024 nt
    s_load_dword s16, s[4:5], s3
    s_load_dword s17, s[6:7], s13
    s_load_dword s18, s[8:9], s13
    global_load_dwordx4 v[36:39], v16, s[4:5] offset:0 nt
    global_load_dwordx4 v[40:43], v16, s[4:5] offset:1024 nt
    global_load_dwordx4 v[44:47], v16, s[4:5] offset:2048 nt
    global_load_dwordx4 v[48:51], v16, s[4:5] offset:3072 nt
    global_load_dwordx4 v[52:55], v17, s[4:5] offset:-4096 nt
    global_load_dwordx4 v[56:59], v17, s[4:5] offset:-3072 nt
    global_load_dwordx4 v[60:63], v17, s[4:5] offset:-2048 nt
    global_load_dwordx4 v[64:67], v17, s[4:5] offset:-1024 nt
    s_cbranch_vccz L_nb1
    s_barrier
L_nb1:
    global_load_dwordx4 v[68:71], v17, s[4:5] offset:0 nt
    global_load_dwordx4 v[72:75], v17, s[4:5] offset:1024 nt
    global_load_dwordx4 v[76:79], v17, s[4:5] offset:2048 nt
    global_load_dwordx4 v[80:83], v17, s[4:5] offset:3072 nt
    s_bitcmp1_b32 s28, 0
    s_cselect_b32 s19, 0, 16
    s_waitcnt vmcnt(15)
    v_dot2c_f32_bf16 v4, s14, v20
    v_dot2c_f32_bf16 v6, v20, v20
    v_dot2c_f32_bf16 v5, s14, v21
    v_dot2c_f32_bf16 v7, v21, v21
    v_dot2c_f32_bf16 v4, s14, v22
    v_dot2c_f32_bf16 v6, v22, v22
    v_dot2c_f32_bf16 v5, s14, v23
    v_dot2c_f32_bf16 v7, v23, v23
    s_waitcnt lgkmcnt(0)
    s_lshl_b32 s16, s16, 16
    s_lshl_b32 s17, s17, s19
    s_and_b32 s17, s17, s15
    s_lshl_b32 s18, s18, s19
    s_and_b32 s18, s18, s15
    v_mov_b32 v8, 0x43000000
    v_mul_f32 v8, s16, v8
    s_waitcnt vmcnt(14)
    v_dot2c_f32_bf16 v4, s14, v24
    v_dot2c_f32_bf16 v6, v24, v24
    v_dot2c_f32_bf16 v5, s14, v25
    v_dot2c_f32_bf16 v7, v25, v25
    v_dot2c_f32_bf16 v4, s14, v26
    v_dot2c_f32_bf16 v6, v26, v26
    v_dot2c_f32_bf16 v5, s14, v27
    v_dot2c_f32_bf16 v7, v27, v27
    s_waitcnt vmcnt(13)
    v_dot2c_f32_bf16 v4, s14, v28
    v_dot2c_f32_bf16 v6, v28, v28
    v_dot2c_f32_bf16 v5, s14, v29
    v_dot2c_f32_bf16 v7, v29, v29
    v_dot2c_f32_bf16 v4, s14, v30
    v_dot2c_f32_bf16 v6, v30, v30
    v_dot2c_f32_bf16 v5, s14, v31
    v_dot2c_f32_bf16 v7, v31, v31
    s_waitcnt vmcnt(12)
    v_dot2c_f32_bf16 v4, s14, v32
    v_dot2c_f32_bf16 v6, v32, v32
    v_dot2c_f32_bf16 v5, s14, v33
    v_dot2c_f32_bf16 v7, v33, v33
    v_dot2c_f32_bf16 v4, s14, v34
    v_dot2c_f32_bf16 v6, v34, v34
    v_dot2c_f32_bf16 v5, s14, v35
    v_dot2c_f32_bf16 v7, v35, v35
    s_waitcnt vmcnt(11)
    v_dot2c_f32_bf16 v4, s14, v36
    v_dot2c_f32_bf16 v6, v36, v36
    v_dot2c_f32_bf16 v5, s14, v37
    v_dot2c_f32_bf16 v7, v37, v37
    v_dot2c_f32_bf16 v4, s14, v38
    v_dot2c_f32_bf16 v6, v38, v38
    v_dot2c_f32_bf16 v5, s14, v39
    v_dot2c_f32_bf16 v7, v39, v39
    s_waitcnt vmcnt(10)
    v_dot2c_f32_bf16 v4, s14, v40
    v_dot2c_f32_bf16 v6, v40, v40
    v_dot2c_f32_bf16 v5, s14, v41
    v_dot2c_f32_bf16 v7, v41, v41
    v_dot2c_f32_bf16 v4, s14, v42
    v_dot2c_f32_bf16 v6, v42, v42
    v_dot2c_f32_bf16 v5, s14, v43
    v_dot2c_f32_bf16 v7, v43, v43
    s_waitcnt vmcnt(9)
    v_dot2c_f32_bf16 v4, s14, v44
    v_dot2c_f32_bf16 v6, v44, v44
    v_dot2c_f32_bf16 v5, s14, v45
    v_dot2c_f32_bf16 v7, v45, v45
    v_dot2c_f32_bf16 v4, s14, v46
    v_dot2c_f32_bf16 v6, v46, v46
    v_dot2c_f32_bf16 v5, s14, v47
    v_dot2c_f32_bf16 v7, v47, v47
    s_waitcnt vmcnt(8)
    v_dot2c_f32_bf16 v4, s14, v48
    v_dot2c_f32_bf16 v6, v48, v48
    v_dot2c_f32_bf16 v5, s14, v49
    v_dot2c_f32_bf16 v7, v49, v49
    v_dot2c_f32_bf16 v4, s14, v50
    v_dot2c_f32_bf16 v6, v50, v50
    v_dot2c_f32_bf16 v5, s14, v51
    v_dot2c_f32_bf16 v7, v51, v51
    s_waitcnt vmcnt(7)
    v_dot2c_f32_bf16 v4, s14, v52
    v_dot2c_f32_bf16 v6, v52, v52
    v_dot2c_f32_bf16 v5, s14, v53
    v_dot2c_f32_bf16 v7, v53, v53
    v_dot2c_f32_bf16 v4, s14, v54
    v_dot2c_f32_bf16 v6, v54, v54
    v_dot2c_f32_bf16 v5, s14, v55
    v_dot2c_f32_bf16 v7, v55, v55
    s_waitcnt vmcnt(6)
    v_dot2c_f32_bf16 v4, s14, v56
    v_dot2c_f32_bf16 v6, v56, v56
    v_dot2c_f32_bf16 v5, s14, v57
    v_dot2c_f32_bf16 v7, v57, v57
    v_dot2c_f32_bf16 v4, s14, v58
    v_dot2c_f32_bf16 v6, v58, v58
    v_dot2c_f32_bf16 v5, s14, v59
    v_dot2c_f32_bf16 v7, v59, v59
    s_waitcnt vmcnt(5)
    v_dot2c_f32_bf16 v4, s14, v60
    v_dot2c_f32_bf16 v6, v60, v60
    v_dot2c_f32_bf16 v5, s14, v61
    v_dot2c_f32_bf16 v7, v61, v61
    v_dot2c_f32_bf16 v4, s14, v62
    v_dot2c_f32_bf16 v6, v62, v62
    v_dot2c_f32_bf16 v5, s14, v63
    v_dot2c_f32_bf16 v7, v63, v63
    s_waitcnt vmcnt(4)
    s_cbranch_vccz L_nb2
    s_barrier
L_nb2:
    v_dot2c_f32_bf16 v4, s14, v64
    v_dot2c_f32_bf16 v6, v64, v64
    v_dot2c_f32_bf16 v5, s14, v65
    v_dot2c_f32_bf16 v7, v65, v65
    v_dot2c_f32_bf16 v4, s14, v66
    v_dot2c_f32_bf16 v6, v66, v66
    v_dot2c_f32_bf16 v5, s14, v67
    v_dot2c_f32_bf16 v7, v67, v67
    s_waitcnt vmcnt(3)
    v_dot2c_f32_bf16 v4, s14, v68
    v_dot2c_f32_bf16 v6, v68, v68
    v_dot2c_f32_bf16 v5, s14, v69
    v_dot2c_f32_bf16 v7, v69, v69
    v_dot2c_f32_bf16 v4, s14, v70
    v_dot2c_f32_bf16 v6, v70, v70
    v_dot2c_f32_bf16 v5, s14, v71
    v_dot2c_f32_bf16 v7, v71, v71
    s_waitcnt vmcnt(2)
    v_dot2c_f32_bf16 v4, s14, v72
    v_dot2c_f32_bf16 v6, v72, v72
    v_dot2c_f32_bf16 v5, s14, v73
    v_dot2c_f32_bf16 v7, v73, v73
    v_dot2c_f32_bf16 v4, s14, v74
    v_dot2c_f32_bf16 v6, v74, v74
    v_dot2c_f32_bf16 v5, s14, v75
    v_dot2c_f32_bf16 v7, v75, v75
    s_waitcnt vmcnt(1)
    v_dot2c_f32_bf16 v4, s14, v76
    v_dot2c_f32_bf16 v6, v76, v76
    v_dot2c_f32_bf16 v5, s14, v77
    v_dot2c_f32_bf16 v7, v77, v77
    v_dot2c_f32_bf16 v4, s14, v78
    v_dot2c_f32_bf16 v6, v78, v78
    v_dot2c_f32_bf16 v5, s14, v79
    v_dot2c_f32_bf16 v7, v79, v79
    s_waitcnt vmcnt(0)
    v_dot2c_f32_bf16 v4, s14, v80
    v_dot2c_f32_bf16 v6, v80, v80
    v_dot2c_f32_bf16 v5, s14, v81
    v_dot2c_f32_bf16 v7, v81, v81
    v_dot2c_f32_bf16 v4, s14, v82
    v_dot2c_f32_bf16 v6, v82, v82
    v_dot2c_f32_bf16 v5, s14, v83
    v_dot2c_f32_bf16 v7, v83, v83
    s_mov_b32 s20, 0
    s_brev_b32 s21, 1
L_pad0:
    s_cbranch_execz L_resume
    s_nop 0
    v_add_f32 v4, v4, v5
    v_add_f32 v6, v6, v7
    v_sub_f32 v10, v4, v8
    v_add_f32 v5, v10, v4
    v_fma_f32 v11, -s16, v5, v6
    v_add_f32_dpp v10, v10, v10 quad_perm:[1,0,3,2] row_mask:0xf bank_mask:0xf
    s_nop 0
    v_add_f32_dpp v11, v11, v11 quad_perm:[1,0,3,2] row_mask:0xf bank_mask:0xf
    v_add_f32_dpp v10, v10, v10 quad_perm:[2,3,0,1] row_mask:0xf bank_mask:0xf
    s_nop 0
    v_add_f32_dpp v11, v11, v11 quad_perm:[2,3,0,1] row_mask:0xf bank_mask:0xf
    v_add_f32_dpp v10, v10, v10 row_half_mirror row_mask:0xf bank_mask:0xf
    s_nop 0
    v_add_f32_dpp v11, v11, v11 row_half_mirror row_mask:0xf bank_mask:0xf
    v_add_f32_dpp v10, v10, v10 row_mirror row_mask:0xf bank_mask:0xf
    s_nop 0
    v_add_f32_dpp v11, v11, v11 row_mirror row_mask:0xf bank_mask:0xf
    v_add_f32_dpp v10, v10, v10 row_bcast:15 row_mask:0xa bank_mask:0xf
    s_nop 0
    v_add_f32_dpp v11, v11, v11 row_bcast:15 row_mask:0xa bank_mask:0xf
    v_add_f32_dpp v10, v10, v10 row_bcast:31 row_mask:0xc bank_mask:0xf
    s_nop 0
    v_add_f32_dpp v11, v11, v11 row_bcast:31 row_mask:0xc bank_mask:0xf
    s_mov_b64 exec, s[20:21]
    ds_write_b64 v3, v[10:11]
    s_mov_b64 exec, -1
    s_waitcnt lgkmcnt(0)
    s_barrier
    ds_read_b128 v[84:87], v2 offset:0
    ds_read_b128 v[88:91], v2 offset:16
    s_waitcnt lgkmcnt(0)
    v_pk_add_f32 v[84:85], v[84:85], v[88:89]
    v_pk_add_f32 v[86:87], v[86:87], v[90:91]
    v_pk_add_f32 v[84:85], v[84:85], v[86:87]
    v_mul_f32 v4, 0x38000000, v84
    v_mul_f32 v5, 0x38000000, v85
    v_add_f32 v6, s16, v4
    v_cvt_pk_bf16_f32 v6, v6, v6
    v_lshlrev_b32 v6, 16, v6
    v_subrev_f32 v7, s16, v6
    v_fma_f32 v8, -2.0, v4, v7
    v_fma_f32 v5, v7, v8, v5
    v_max_f32 v5, 0, v5
    v_cvt_pk_bf16_f32 v5, v5, v5
    v_lshlrev_b32 v5, 16, v5
    v_add_f32 v5, 0x3727c5ac, v5
    v_cvt_pk_bf16_f32 v5, v5, v5
    v_lshlrev_b32 v5, 16, v5
    v_sqrt_f32 v5, v5
    s_nop 0
    v_cvt_pk_bf16_f32 v5, v5, v5
    v_lshlrev_b32 v5, 16, v5
    v_rcp_f32 v5, v5
    v_mov_b32 v9, s18
    v_mul_f32 v8, s17, v5
    v_xor_b32 v6, 0x80000000, v6
    s_mov_b32 s24, 0x00003f80
    s_mov_b32 s25, 0x3f800000
    v_dot2_f32_bf16 v10, v20, s24, v6
    v_dot2_f32_bf16 v11, v20, s25, v6
    v_dot2_f32_bf16 v12, v21, s24, v6
    v_dot2_f32_bf16 v13, v21, s25, v6
    v_dot2_f32_bf16 v14, v22, s24, v6
    v_dot2_f32_bf16 v15, v22, s25, v6
    v_dot2_f32_bf16 v4, v23, s24, v6
    v_dot2_f32_bf16 v5, v23, s25, v6
    v_pk_fma_f32 v[10:11], v[10:11], v[8:9], v[8:9] op_sel:[0,0,1] op_sel_hi:[1,0,1]
    v_pk_fma_f32 v[12:13], v[12:13], v[8:9], v[8:9] op_sel:[0,0,1] op_sel_hi:[1,0,1]
    v_pk_fma_f32 v[14:15], v[14:15], v[8:9], v[8:9] op_sel:[0,0,1] op_sel_hi:[1,0,1]
    v_pk_fma_f32 v[4:5], v[4:5], v[8:9], v[8:9] op_sel:[0,0,1] op_sel_hi:[1,0,1]
    v_cvt_pk_bf16_f32 v20, v10, v11
    v_cvt_pk_bf16_f32 v21, v12, v13
    v_cvt_pk_bf16_f32 v22, v14, v15
    v_cvt_pk_bf16_f32 v23, v4, v5
    v_dot2_f32_bf16 v10, v24, s24, v6
    v_dot2_f32_bf16 v11, v24, s25, v6
    v_dot2_f32_bf16 v12, v25, s24, v6
    v_dot2_f32_bf16 v13, v25, s25, v6
    v_dot2_f32_bf16 v14, v26, s24, v6
    v_dot2_f32_bf16 v15, v26, s25, v6
    v_dot2_f32_bf16 v4, v27, s24, v6
    v_dot2_f32_bf16 v5, v27, s25, v6
    v_pk_fma_f32 v[10:11], v[10:11], v[8:9], v[8:9] op_sel:[0,0,1] op_sel_hi:[1,0,1]
    v_pk_fma_f32 v[12:13], v[12:13], v[8:9], v[8:9] op_sel:[0,0,1] op_sel_hi:[1,0,1]
    v_pk_fma_f32 v[14:15], v[14:15], v[8:9], v[8:9] op_sel:[0,0,1] op_sel_hi:[1,0,1]
    v_pk_fma_f32 v[4:5], v[4:5], v[8:9], v[8:9] op_sel:[0,0,1] op_sel_hi:[1,0,1]
    v_cvt_pk_bf16_f32 v24, v10, v11
    v_cvt_pk_bf16_f32 v25, v12, v13
    v_cvt_pk_bf16_f32 v26, v14, v15
    v_cvt_pk_bf16_f32 v27, v4, v5
    v_dot2_f32_bf16 v10, v28, s24, v6
    v_dot2_f32_bf16 v11, v28, s25, v6
    v_dot2_f32_bf16 v12, v29, s24, v6
    v_dot2_f32_bf16 v13, v29, s25, v6
    v_dot2_f32_bf16 v14, v30, s24, v6
    v_dot2_f32_bf16 v15, v30, s25, v6
    v_dot2_f32_bf16 v4, v31, s24, v6
    v_dot2_f32_bf16 v5, v31, s25, v6
    v_pk_fma_f32 v[10:11], v[10:11], v[8:9], v[8:9] op_sel:[0,0,1] op_sel_hi:[1,0,1]
    v_pk_fma_f32 v[12:13], v[12:13], v[8:9], v[8:9] op_sel:[0,0,1] op_sel_hi:[1,0,1]
    v_pk_fma_f32 v[14:15], v[14:15], v[8:9], v[8:9] op_sel:[0,0,1] op_sel_hi:[1,0,1]
    v_pk_fma_f32 v[4:5], v[4:5], v[8:9], v[8:9] op_sel:[0,0,1] op_sel_hi:[1,0,1]
    v_cvt_pk_bf16_f32 v28, v10, v11
    v_cvt_pk_bf16_f32 v29, v12, v13
    v_cvt_pk_bf16_f32 v30, v14, v15
    v_cvt_pk_bf16_f32 v31, v4, v5
    v_dot2_f32_bf16 v10, v32, s24, v6
    v_dot2_f32_bf16 v11, v32, s25, v6
    v_dot2_f32_bf16 v12, v33, s24, v6
    v_dot2_f32_bf16 v13, v33, s25, v6
    v_dot2_f32_bf16 v14, v34, s24, v6
    v_dot2_f32_bf16 v15, v34, s25, v6
    v_dot2_f32_bf16 v4, v35, s24, v6
    v_dot2_f32_bf16 v5, v35, s25, v6
    v_pk_fma_f32 v[10:11], v[10:11], v[8:9], v[8:9] op_sel:[0,0,1] op_sel_hi:[1,0,1]
    v_pk_fma_f32 v[12:13], v[12:13], v[8:9], v[8:9] op_sel:[0,0,1] op_sel_hi:[1,0,1]
    v_pk_fma_f32 v[14:15], v[14:15], v[8:9], v[8:9] op_sel:[0,0,1] op_sel_hi:[1,0,1]
    v_pk_fma_f32 v[4:5], v[4:5], v[8:9], v[8:9] op_sel:[0,0,1] op_sel_hi:[1,0,1]
    v_cvt_pk_bf16_f32 v32, v10, v11
    v_cvt_pk_bf16_f32 v33, v12, v13
    v_cvt_pk_bf16_f32 v34, v14, v15
    v_cvt_pk_bf16_f32 v35, v4, v5
    v_dot2_f32_bf16 v10, v36, s24, v6
    v_dot2_f32_bf16 v11, v36, s25, v6
    v_dot2_f32_bf16 v12, v37, s24, v6
    v_dot2_f32_bf16 v13, v37, s25, v6
    v_dot2_f32_bf16 v14, v38, s24, v6
    v_dot2_f32_bf16 v15, v38, s25, v6
    v_dot2_f32_bf16 v4, v39, s24, v6
    v_dot2_f32_bf16 v5, v39, s25, v6
    v_pk_fma_f32 v[10:11], v[10:11], v[8:9], v[8:9] op_sel:[0,0,1] op_sel_hi:[1,0,1]
    v_pk_fma_f32 v[12:13], v[12:13], v[8:9], v[8:9] op_sel:[0,0,1] op_sel_hi:[1,0,1]
    v_pk_fma_f32 v[14:15], v[14:15], v[8:9], v[8:9] op_sel:[0,0,1] op_sel_hi:[1,0,1]
    v_pk_fma_f32 v[4:5], v[4:5], v[8:9], v[8:9] op_sel:[0,0,1] op_sel_hi:[1,0,1]
    v_cvt_pk_bf16_f32 v36, v10, v11
    v_cvt_pk_bf16_f32 v37, v12, v13
    v_cvt_pk_bf16_f32 v38, v14, v15
    v_cvt_pk_bf16_f32 v39, v4, v5
    v_dot2_f32_bf16 v10, v40, s24, v6
    v_dot2_f32_bf16 v11, v40, s25, v6
    v_dot2_f32_bf16 v12, v41, s24, v6
    v_dot2_f32_bf16 v13, v41, s25, v6
    v_dot2_f32_bf16 v14, v42, s24, v6
    v_dot2_f32_bf16 v15, v42, s25, v6
    v_dot2_f32_bf16 v4, v43, s24, v6
    v_dot2_f32_bf16 v5, v43, s25, v6
    v_pk_fma_f32 v[10:11], v[10:11], v[8:9], v[8:9] op_sel:[0,0,1] op_sel_hi:[1,0,1]
    v_pk_fma_f32 v[12:13], v[12:13], v[8:9], v[8:9] op_sel:[0,0,1] op_sel_hi:[1,0,1]
    v_pk_fma_f32 v[14:15], v[14:15], v[8:9], v[8:9] op_sel:[0,0,1] op_sel_hi:[1,0,1]
    v_pk_fma_f32 v[4:5], v[4:5], v[8:9], v[8:9] op_sel:[0,0,1] op_sel_hi:[1,0,1]
    v_cvt_pk_bf16_f32 v40, v10, v11
    v_cvt_pk_bf16_f32 v41, v12, v13
    v_cvt_pk_bf16_f32 v42, v14, v15
    v_cvt_pk_bf16_f32 v43, v4, v5
L_pad1:
    s_cbranch_execz L_resume
    v_dot2_f32_bf16 v10, v44, s24, v6
    v_dot2_f32_bf16 v11, v44, s25, v6
    v_dot2_f32_bf16 v12, v45, s24, v6
    v_dot2_f32_bf16 v13, v45, s25, v6
    v_dot2_f32_bf16 v14, v46, s24, v6
    v_dot2_f32_bf16 v15, v46, s25, v6
    v_dot2_f32_bf16 v4, v47, s24, v6
    v_dot2_f32_bf16 v5, v47, s25, v6
    v_pk_fma_f32 v[10:11], v[10:11], v[8:9], v[8:9] op_sel:[0,0,1] op_sel_hi:[1,0,1]
    v_pk_fma_f32 v[12:13], v[12:13], v[8:9], v[8:9] op_sel:[0,0,1] op_sel_hi:[1,0,1]
    v_pk_fma_f32 v[14:15], v[14:15], v[8:9], v[8:9] op_sel:[0,0,1] op_sel_hi:[1,0,1]
    v_pk_fma_f32 v[4:5], v[4:5], v[8:9], v[8:9] op_sel:[0,0,1] op_sel_hi:[1,0,1]
    v_cvt_pk_bf16_f32 v44, v10, v11
    v_cvt_pk_bf16_f32 v45, v12, v13
    v_cvt_pk_bf16_f32 v46, v14, v15
    v_cvt_pk_bf16_f32 v47, v4, v5
    v_dot2_f32_bf16 v10, v48, s24, v6
    v_dot2_f32_bf16 v11, v48, s25, v6
    v_dot2_f32_bf16 v12, v49, s24, v6
    v_dot2_f32_bf16 v13, v49, s25, v6
    v_dot2_f32_bf16 v14, v50, s24, v6
    v_dot2_f32_bf16 v15, v50, s25, v6
    v_dot2_f32_bf16 v4, v51, s24, v6
    v_dot2_f32_bf16 v5, v51, s25, v6
    v_pk_fma_f32 v[10:11], v[10:11], v[8:9], v[8:9] op_sel:[0,0,1] op_sel_hi:[1,0,1]
    v_pk_fma_f32 v[12:13], v[12:13], v[8:9], v[8:9] op_sel:[0,0,1] op_sel_hi:[1,0,1]
    v_pk_fma_f32 v[14:15], v[14:15], v[8:9], v[8:9] op_sel:[0,0,1] op_sel_hi:[1,0,1]
    v_pk_fma_f32 v[4:5], v[4:5], v[8:9], v[8:9] op_sel:[0,0,1] op_sel_hi:[1,0,1]
    v_cvt_pk_bf16_f32 v48, v10, v11
    v_cvt_pk_bf16_f32 v49, v12, v13
    v_cvt_pk_bf16_f32 v50, v14, v15
    v_cvt_pk_bf16_f32 v51, v4, v5
    v_dot2_f32_bf16 v10, v52, s24, v6
    v_dot2_f32_bf16 v11, v52, s25, v6
    v_dot2_f32_bf16 v12, v53, s24, v6
    v_dot2_f32_bf16 v13, v53, s25, v6
    v_dot2_f32_bf16 v14, v54, s24, v6
    v_dot2_f32_bf16 v15, v54, s25, v6
    v_dot2_f32_bf16 v4, v55, s24, v6
    v_dot2_f32_bf16 v5, v55, s25, v6
    v_pk_fma_f32 v[10:11], v[10:11], v[8:9], v[8:9] op_sel:[0,0,1] op_sel_hi:[1,0,1]
    v_pk_fma_f32 v[12:13], v[12:13], v[8:9], v[8:9] op_sel:[0,0,1] op_sel_hi:[1,0,1]
    v_pk_fma_f32 v[14:15], v[14:15], v[8:9], v[8:9] op_sel:[0,0,1] op_sel_hi:[1,0,1]
    v_pk_fma_f32 v[4:5], v[4:5], v[8:9], v[8:9] op_sel:[0,0,1] op_sel_hi:[1,0,1]
    v_cvt_pk_bf16_f32 v52, v10, v11
    v_cvt_pk_bf16_f32 v53, v12, v13
    v_cvt_pk_bf16_f32 v54, v14, v15
    v_cvt_pk_bf16_f32 v55, v4, v5
    v_dot2_f32_bf16 v10, v56, s24, v6
    v_dot2_f32_bf16 v11, v56, s25, v6
    v_dot2_f32_bf16 v12, v57, s24, v6
    v_dot2_f32_bf16 v13, v57, s25, v6
    v_dot2_f32_bf16 v14, v58, s24, v6
    v_dot2_f32_bf16 v15, v58, s25, v6
    v_dot2_f32_bf16 v4, v59, s24, v6
    v_dot2_f32_bf16 v5, v59, s25, v6
    v_pk_fma_f32 v[10:11], v[10:11], v[8:9], v[8:9] op_sel:[0,0,1] op_sel_hi:[1,0,1]
    v_pk_fma_f32 v[12:13], v[12:13], v[8:9], v[8:9] op_sel:[0,0,1] op_sel_hi:[1,0,1]
    v_pk_fma_f32 v[14:15], v[14:15], v[8:9], v[8:9] op_sel:[0,0,1] op_sel_hi:[1,0,1]
    v_pk_fma_f32 v[4:5], v[4:5], v[8:9], v[8:9] op_sel:[0,0,1] op_sel_hi:[1,0,1]
    v_cvt_pk_bf16_f32 v56, v10, v11
    v_cvt_pk_bf16_f32 v57, v12, v13
    v_cvt_pk_bf16_f32 v58, v14, v15
    v_cvt_pk_bf16_f32 v59, v4, v5
    v_dot2_f32_bf16 v10, v60, s24, v6
    v_dot2_f32_bf16 v11, v60, s25, v6
    v_dot2_f32_bf16 v12, v61, s24, v6
    v_dot2_f32_bf16 v13, v61, s25, v6
    v_dot2_f32_bf16 v14, v62, s24, v6
    v_dot2_f32_bf16 v15, v62, s25, v6
    v_dot2_f32_bf16 v4, v63, s24, v6
    v_dot2_f32_bf16 v5, v63, s25, v6
    v_pk_fma_f32 v[10:11], v[10:11], v[8:9], v[8:9] op_sel:[0,0,1] op_sel_hi:[1,0,1]
    v_pk_fma_f32 v[12:13], v[12:13], v[8:9], v[8:9] op_sel:[0,0,1] op_sel_hi:[1,0,1]
    v_pk_fma_f32 v[14:15], v[14:15], v[8:9], v[8:9] op_sel:[0,0,1] op_sel_hi:[1,0,1]
    v_pk_fma_f32 v[4:5], v[4:5], v[8:9], v[8:9] op_sel:[0,0,1] op_sel_hi:[1,0,1]
    v_cvt_pk_bf16_f32 v60, v10, v11
    v_cvt_pk_bf16_f32 v61, v12, v13
    v_cvt_pk_bf16_f32 v62, v14, v15
    v_cvt_pk_bf16_f32 v63, v4, v5
    v_dot2_f32_bf16 v10, v64, s24, v6
    v_dot2_f32_bf16 v11, v64, s25, v6
    v_dot2_f32_bf16 v12, v65, s24, v6
    v_dot2_f32_bf16 v13, v65, s25, v6
    v_dot2_f32_bf16 v14, v66, s24, v6
    v_dot2_f32_bf16 v15, v66, s25, v6
    v_dot2_f32_bf16 v4, v67, s24, v6
    v_dot2_f32_bf16 v5, v67, s25, v6
    v_pk_fma_f32 v[10:11], v[10:11], v[8:9], v[8:9] op_sel:[0,0,1] op_sel_hi:[1,0,1]
    v_pk_fma_f32 v[12:13], v[12:13], v[8:9], v[8:9] op_sel:[0,0,1] op_sel_hi:[1,0,1]
    v_pk_fma_f32 v[14:15], v[14:15], v[8:9], v[8:9] op_sel:[0,0,1] op_sel_hi:[1,0,1]
    v_pk_fma_f32 v[4:5], v[4:5], v[8:9], v[8:9] op_sel:[0,0,1] op_sel_hi:[1,0,1]
    v_cvt_pk_bf16_f32 v64, v10, v11
    v_cvt_pk_bf16_f32 v65, v12, v13
    v_cvt_pk_bf16_f32 v66, v14, v15
    v_cvt_pk_bf16_f32 v67, v4, v5
    v_dot2_f32_bf16 v10, v68, s24, v6
    v_dot2_f32_bf16 v11, v68, s25, v6
    v_dot2_f32_bf16 v12, v69, s24, v6
    v_dot2_f32_bf16 v13, v69, s25, v6
    v_dot2_f32_bf16 v14, v70, s24, v6
    v_dot2_f32_bf16 v15, v70, s25, v6
    v_dot2_f32_bf16 v4, v71, s24, v6
    v_dot2_f32_bf16 v5, v71, s25, v6
    v_pk_fma_f32 v[10:11], v[10:11], v[8:9], v[8:9] op_sel:[0,0,1] op_sel_hi:[1,0,1]
    v_pk_fma_f32 v[12:13], v[12:13], v[8:9], v[8:9] op_sel:[0,0,1] op_sel_hi:[1,0,1]
    v_pk_fma_f32 v[14:15], v[14:15], v[8:9], v[8:9] op_sel:[0,0,1] op_sel_hi:[1,0,1]
    v_pk_fma_f32 v[4:5], v[4:5], v[8:9], v[8:9] op_sel:[0,0,1] op_sel_hi:[1,0,1]
    v_cvt_pk_bf16_f32 v68, v10, v11
    v_cvt_pk_bf16_f32 v69, v12, v13
    v_cvt_pk_bf16_f32 v70, v14, v15
    v_cvt_pk_bf16_f32 v71, v4, v5
    v_dot2_f32_bf16 v10, v72, s24, v6
    v_dot2_f32_bf16 v11, v72, s25, v6
    v_dot2_f32_bf16 v12, v73, s24, v6
    v_dot2_f32_bf16 v13, v73, s25, v6
    v_dot2_f32_bf16 v14, v74, s24, v6
    v_dot2_f32_bf16 v15, v74, s25, v6
    v_dot2_f32_bf16 v4, v75, s24, v6
    v_dot2_f32_bf16 v5, v75, s25, v6
    v_pk_fma_f32 v[10:11], v[10:11], v[8:9], v[8:9] op_sel:[0,0,1] op_sel_hi:[1,0,1]
    v_pk_fma_f32 v[12:13], v[12:13], v[8:9], v[8:9] op_sel:[0,0,1] op_sel_hi:[1,0,1]
    v_pk_fma_f32 v[14:15], v[14:15], v[8:9], v[8:9] op_sel:[0,0,1] op_sel_hi:[1,0,1]
    v_pk_fma_f32 v[4:5], v[4:5], v[8:9], v[8:9] op_sel:[0,0,1] op_sel_hi:[1,0,1]
    v_cvt_pk_bf16_f32 v72, v10, v11
    v_cvt_pk_bf16_f32 v73, v12, v13
    v_cvt_pk_bf16_f32 v74, v14, v15
    v_cvt_pk_bf16_f32 v75, v4, v5
    v_dot2_f32_bf16 v10, v76, s24, v6
    v_dot2_f32_bf16 v11, v76, s25, v6
    v_dot2_f32_bf16 v12, v77, s24, v6
    v_dot2_f32_bf16 v13, v77, s25, v6
    v_dot2_f32_bf16 v14, v78, s24, v6
    v_dot2_f32_bf16 v15, v78, s25, v6
    v_dot2_f32_bf16 v4, v79, s24, v6
    v_dot2_f32_bf16 v5, v79, s25, v6
    v_pk_fma_f32 v[10:11], v[10:11], v[8:9], v[8:9] op_sel:[0,0,1] op_sel_hi:[1,0,1]
    v_pk_fma_f32 v[12:13], v[12:13], v[8:9], v[8:9] op_sel:[0,0,1] op_sel_hi:[1,0,1]
    v_pk_fma_f32 v[14:15], v[14:15], v[8:9], v[8:9] op_sel:[0,0,1] op_sel_hi:[1,0,1]
    v_pk_fma_f32 v[4:5], v[4:5], v[8:9], v[8:9] op_sel:[0,0,1] op_sel_hi:[1,0,1]
    v_cvt_pk_bf16_f32 v76, v10, v11
    v_cvt_pk_bf16_f32 v77, v12, v13
    v_cvt_pk_bf16_f32 v78, v14, v15
    v_cvt_pk_bf16_f32 v79, v4, v5
    v_dot2_f32_bf16 v10, v80, s24, v6
    v_dot2_f32_bf16 v11, v80, s25, v6
    v_dot2_f32_bf16 v12, v81, s24, v6
    v_dot2_f32_bf16 v13, v81, s25, v6
    v_dot2_f32_bf16 v14, v82, s24, v6
    v_dot2_f32_bf16 v15, v82, s25, v6
    v_dot2_f32_bf16 v4, v83, s24, v6
    v_dot2_f32_bf16 v5, v83, s25, v6
L_pad2:
    s_cbranch_execz L_resume
    v_pk_fma_f32 v[10:11], v[10:11], v[8:9], v[8:9] op_sel:[0,0,1] op_sel_hi:[1,0,1]
    v_pk_fma_f32 v[12:13], v[12:13], v[8:9], v[8:9] op_sel:[0,0,1] op_sel_hi:[1,0,1]
    v_pk_fma_f32 v[14:15], v[14:15], v[8:9], v[8:9] op_sel:[0,0,1] op_sel_hi:[1,0,1]
    v_pk_fma_f32 v[4:5], v[4:5], v[8:9], v[8:9] op_sel:[0,0,1] op_sel_hi:[1,0,1]
    v_cvt_pk_bf16_f32 v80, v10, v11
    v_cvt_pk_bf16_f32 v81, v12, v13
    v_cvt_pk_bf16_f32 v82, v14, v15
    v_cvt_pk_bf16_f32 v83, v4, v5
    s_cbranch_vccnz L_nb3
    s_barrier
L_nb3:
    global_store_dwordx4 v16, v[20:23], s[10:11] offset:-4096 sc0 sc1
    global_store_dwordx4 v16, v[24:27], s[10:11] offset:-3072 sc0 sc1
    global_store_dwordx4 v16, v[28:31], s[10:11] offset:-2048 sc0 sc1
    global_store_dwordx4 v16, v[32:35], s[10:11] offset:-1024 sc0 sc1
    global_store_dwordx4 v16, v[36:39], s[10:11] offset:0 sc0 sc1
    global_store_dwordx4 v16, v[40:43], s[10:11] offset:1024 sc0 sc1
    global_store_dwordx4 v16, v[44:47], s[10:11] offset:2048 sc0 sc1
    global_store_dwordx4 v16, v[48:51], s[10:11] offset:3072 sc0 sc1
    s_cbranch_vccnz L_nb4
    s_barrier
L_nb4:
    global_store_dwordx4 v17, v[52:55], s[10:11] offset:-4096 sc0 sc1
    global_store_dwordx4 v17, v[56:59], s[10:11] offset:-3072 sc0 sc1
    global_store_dwordx4 v17, v[60:63], s[10:11] offset:-2048 sc0 sc1
    global_store_dwordx4 v17, v[64:67], s[10:11] offset:-1024 sc0 sc1
    global_store_dwordx4 v17, v[68:71], s[10:11] offset:0 sc0 sc1
    global_store_dwordx4 v17, v[72:75], s[10:11] offset:1024 sc0 sc1
    global_store_dwordx4 v17, v[76:79], s[10:11] offset:2048 sc0 sc1
    global_store_dwordx4 v17, v[80:83], s[10:11] offset:3072 sc0 sc1
L_end:
    s_endpgm
.section .rodata,"a"
.p2align 6
.amdhsa_kernel standalone__instancenorm__prompt_kernel
  .amdhsa_next_free_vgpr 92
  .amdhsa_next_free_sgpr 32
  .amdhsa_accum_offset 92
  .amdhsa_group_segment_fixed_size 0
  .amdhsa_kernarg_size 48
  .amdhsa_user_sgpr_count 2
  .amdhsa_user_sgpr_kernarg_segment_ptr 1
  .amdhsa_system_sgpr_workgroup_id_x 1
  .amdhsa_float_denorm_mode_32 3
.end_amdhsa_kernel
```
